```python
import torch

def _softmax(x, axis=-1):
    return torch.softmax(x, dim=axis)
def _gelu(x):
    return torch.nn.functional.gelu(x, approximate="tanh")
def _silu(x):
    return torch.nn.functional.silu(x)
def _sigmoid(x):
    return torch.sigmoid(x)
def _layernorm(x, axis=-1, eps=1e-5):
    m = x.mean(dim=axis, keepdim=True)
    v = x.var(dim=axis, keepdim=True, unbiased=False)
    return (x - m) / torch.sqrt(v + eps)
def _scatter_add(tgt, idx, src, axis=0):
    return tgt.clone().index_add_(axis, idx, src)
def _segment_sum(src, seg, n):
    out = torch.zeros((n,) + src.shape[1:], dtype=src.dtype)
    return out.index_add_(0, seg, src)
def _pad(x, pw):
    flat = tuple(v for pair in reversed(pw) for v in pair)
    return torch.nn.functional.pad(x, flat)

kernel_name = 'sequential_preLN__sliding_block_cached__glu_gated_reglu__decode'

def setup_inputs():

    _w = (lambda a: (lambda t: t.to(torch.bfloat16) if t.is_floating_point() else t)(torch.as_tensor(a)))
    def _A_setup():
        B, Sq, D = 1, 1, 512
        Hq, Hkv, Sk, Dh = 32, 32, 32768, 128
        assert Hq % Hkv == 0, (Hq, Hkv)
        return {
            "x": _w((lambda *s: torch.randn(*s, dtype=torch.bfloat16) * 0.05)(B, Sq, D)),
            "k_cache": _w((lambda *s: torch.randn(*s, dtype=torch.bfloat16) * 1.6)(B, Hkv, Sk, Dh)),
            "v_cache": _w((lambda *s: torch.randn(*s, dtype=torch.bfloat16) * 0.8)(B, Hkv, Sk, Dh)),
            "wq": _w((lambda *s: torch.randn(*s, dtype=torch.bfloat16) * 1.6)(D, Hq * Dh) * (D ** -0.5)),
            "wo": _w((lambda *s: torch.randn(*s, dtype=torch.bfloat16) * 0.8)(Hq * Dh, D) * ((Hq * Dh) ** -0.5)),
        }
    _A_in = _A_setup()

    def _B_setup():
        B, S, D, F = 1, 1, 512, 1376
        return {
            "x": _w((lambda *s: torch.randn(*s, dtype=torch.bfloat16) * 0.05)(B, S, D)),
            "W_gate": _w((lambda *s: torch.randn(*s, dtype=torch.bfloat16) * 0.4)(D, F) * (2.0 / D) ** 0.5),
            "W_up": _w((lambda *s: torch.randn(*s, dtype=torch.bfloat16) * 0.4)(D, F) * (2.0 / D) ** 0.5),
            "W_down": _w((lambda *s: torch.randn(*s, dtype=torch.bfloat16) * 0.4)(F, D) * (1.0 / F) ** 0.5),
        }
    _B_in = _B_setup()

    return {
        "A_x": _A_in["x"],
        "A_k_cache": _A_in["k_cache"],
        "A_v_cache": _A_in["v_cache"],
        "A_wq": _A_in["wq"],
        "A_wo": _A_in["wo"],
        "B_x": _B_in["x"],
        "B_W_gate": _B_in["W_gate"],
        "B_W_up": _B_in["W_up"],
        "B_W_down": _B_in["W_down"],
    }

def reference(A_x, A_k_cache, A_v_cache, A_wq, A_wo, B_x, B_W_gate, B_W_up, B_W_down):
    def _A_ref(x, k_cache, v_cache, wq, wo):
        B, Sq, D = x.shape
        Hq, Dh = 32, 128
        Hkv, Sk = k_cache.shape[1], k_cache.shape[2]
        W = min(4096, max(256, Sk // 4))
        rep = Hq // Hkv
        q = (lambda x, *d: x.permute(*d))((x @ wq).reshape(B, Sq, Hq, Dh), 0, 2, 1, 3)
        k = (lambda x, n, axis: torch.repeat_interleave(x, n, dim=axis))(k_cache[:, :, Sk - W:, :], rep, axis=1)
        v = (lambda x, n, axis: torch.repeat_interleave(x, n, dim=axis))(v_cache[:, :, Sk - W:, :], rep, axis=1)
        scores = torch.einsum("bhqd,bhkd->bhqk", q, k) * (Dh ** -0.5)
        p = _softmax(scores, axis=-1)
        o = torch.einsum("bhqk,bhkd->bhqd", p, v)
        return (lambda x, *d: x.permute(*d))(o, 0, 2, 1, 3).reshape(B, Sq, Hq * Dh) @ wo

    def _B_ref(x, W_gate, W_up, W_down):
        gate = torch.einsum("bsd,df->bsf", x, W_gate)
        up = torch.einsum("bsd,df->bsf", x, W_up)
        gate = gate * (lambda x, dt: x.to(dt))(gate > 0, gate.dtype)
        h = gate * up
        return torch.einsum("bsf,fd->bsd", h, W_down)

    x = A_x
    h = x + _A_ref(_layernorm(x, axis=-1), A_k_cache, A_v_cache, A_wq, A_wo)
    h2 = h + _B_ref(_layernorm(h, axis=-1), B_W_gate, B_W_up, B_W_down)
    return h2
```

```asm
; @launch grid=(256,1,1) block=(1024,1,1) lds=65536
.amdgcn_target "amdgcn-amd-amdhsa--gfx950"
.text
.globl sequential_preLN__sliding_block_cached__glu_gated_reglu__decode_kernel
.p2align 8
.type sequential_preLN__sliding_block_cached__glu_gated_reglu__decode_kernel,@function
sequential_preLN__sliding_block_cached__glu_gated_reglu__decode_kernel:
    s_cmp_ge_u32 s2, 256
    s_cbranch_scc1 Lend
    s_getreg_b32 s48, hwreg(HW_REG_XCC_ID, 0, 4)
    s_load_dwordx16 s[4:19], s[0:1], 0
    s_load_dwordx8 s[20:27], s[0:1], 64
    v_lshrrev_b32 v1, 6, v0
    v_and_b32 v0, 63, v0
    v_mov_b32 v2, 0
    v_readfirstlane_b32 s3, v1
    ds_write_b32 v2, v2 offset:256
    s_and_b32 s28, s2, 31
    s_lshr_b32 s29, s2, 5
    s_and_b32 s30, s2, 7
    s_lshr_b32 s31, s2, 3
    v_lshlrev_b32 v1, 4, v0
    s_lshl_b32 s34, s28, 23
    s_lshl_b32 s35, s29, 17
    s_add_u32 s34, s34, s35
    s_add_u32 s35, s31, s3
    s_and_b32 s35, s35, 15
    s_lshl_b32 s35, s35, 13
    s_add_u32 s34, s34, s35
    s_add_u32 s34, s34, 7344128
    v_and_b32 v4, 15, v0
    s_waitcnt lgkmcnt(0)
    s_add_u32 s6, s6, s34
    s_addc_u32 s7, s7, 0
    s_add_u32 s8, s8, s34
    s_addc_u32 s9, s9, 0
    s_cmp_lg_u32 s31, 0
    s_cbranch_scc1 Lnl
    v_mov_b32 v8, -1
    v_mov_b32 v9, -1
    v_mov_b32 v10, -1
    v_mov_b32 v11, -1
    s_lshr_b32 s40, s3, 2
    s_lshl_b32 s40, s40, 3
    s_add_u32 s40, s40, s30
    s_lshl_b32 s40, s40, 14
    s_and_b32 s41, s3, 3
    s_lshl_b32 s41, s41, 12
    s_add_u32 s40, s40, s41
    s_lshl_b32 s41, s30, 11
    s_lshl_b32 s42, s3, 7
    s_add_u32 s41, s41, s42
    s_add_u32 s42, s41, 557056
    s_add_u32 s41, s41, 524288
    v_add_u32 v12, s40, v1
    v_mov_b32 v13, s41
    v_lshrrev_b32 v14, 3, v0
    v_mov_b32 v15, s42
    v_cmp_eq_u32 vcc, 1, v14
    s_nop 1
    v_cndmask_b32 v13, v13, v15, vcc
    v_and_b32 v14, 0x70, v1
    v_add_u32 v13, v13, v14
    global_store_dwordx4 v12, v[8:11], s[26:27] sc1
    global_store_dwordx4 v12, v[8:11], s[26:27] offset:2048 sc1
    s_mov_b64 exec, 0xffff
    global_store_dwordx4 v13, v[8:11], s[26:27] sc1
    s_mov_b64 exec, -1
Lnl:
    s_cmp_lg_u32 s3, 0
    s_cbranch_scc1 Lnq
    s_setprio 3
    global_load_dwordx4 v[16:19], v1, s[4:5]
    s_add_u32 s42, s2, s31
    v_add_u32 v48, s42, v0
    v_and_b32 v48, 15, v48
    v_and_or_b32 v48, v0, 48, v48
    s_lshl_b32 s40, s29, 7
    v_lshl_add_u32 v48, v48, 1, s40
    v_lshrrev_b32 v49, 4, v0
    v_lshlrev_b32 v49, 17, v49
    v_lshl_add_u32 v49, v4, 4, v49
    s_lshl_b32 s40, s29, 19
    s_lshl_b32 s41, s28, 8
    s_add_u32 s40, s40, s41
    v_add_u32 v49, s40, v49
    global_load_ushort v20, v48, s[4:5]
    s_add_u32 s41, s42, 0
    s_and_b32 s41, s41, 15
    v_lshl_add_u32 v32, s41, 13, v49
    global_load_dwordx4 v[64:67], v32, s[10:11] nt
    s_add_u32 s41, s42, 1
    s_and_b32 s41, s41, 15
    v_lshl_add_u32 v33, s41, 13, v49
    global_load_dwordx4 v[68:71], v33, s[10:11] nt
    s_add_u32 s41, s42, 2
    s_and_b32 s41, s41, 15
    v_lshl_add_u32 v34, s41, 13, v49
    global_load_dwordx4 v[72:75], v34, s[10:11] nt
    s_add_u32 s41, s42, 3
    s_and_b32 s41, s41, 15
    v_lshl_add_u32 v35, s41, 13, v49
    global_load_dwordx4 v[76:79], v35, s[10:11] nt
    s_add_u32 s41, s42, 4
    s_and_b32 s41, s41, 15
    v_lshl_add_u32 v36, s41, 13, v49
    global_load_dwordx4 v[80:83], v36, s[10:11] nt
    s_add_u32 s41, s42, 5
    s_and_b32 s41, s41, 15
    v_lshl_add_u32 v37, s41, 13, v49
    global_load_dwordx4 v[84:87], v37, s[10:11] nt
    s_add_u32 s41, s42, 6
    s_and_b32 s41, s41, 15
    v_lshl_add_u32 v38, s41, 13, v49
    global_load_dwordx4 v[88:91], v38, s[10:11] nt
    s_add_u32 s41, s42, 7
    s_and_b32 s41, s41, 15
    v_lshl_add_u32 v39, s41, 13, v49
    global_load_dwordx4 v[92:95], v39, s[10:11] nt
    s_add_u32 s41, s42, 8
    s_and_b32 s41, s41, 15
    v_lshl_add_u32 v40, s41, 13, v49
    global_load_dwordx4 v[96:99], v40, s[10:11] nt
    s_add_u32 s41, s42, 9
    s_and_b32 s41, s41, 15
    v_lshl_add_u32 v41, s41, 13, v49
    global_load_dwordx4 v[100:103], v41, s[10:11] nt
    s_add_u32 s41, s42, 10
    s_and_b32 s41, s41, 15
    v_lshl_add_u32 v42, s41, 13, v49
    global_load_dwordx4 v[104:107], v42, s[10:11] nt
    s_add_u32 s41, s42, 11
    s_and_b32 s41, s41, 15
    v_lshl_add_u32 v43, s41, 13, v49
    global_load_dwordx4 v[108:111], v43, s[10:11] nt
    s_add_u32 s41, s42, 12
    s_and_b32 s41, s41, 15
    v_lshl_add_u32 v44, s41, 13, v49
    global_load_dwordx4 v[112:115], v44, s[10:11] nt
    s_add_u32 s41, s42, 13
    s_and_b32 s41, s41, 15
    v_lshl_add_u32 v45, s41, 13, v49
    global_load_dwordx4 v[116:119], v45, s[10:11] nt
    s_add_u32 s41, s42, 14
    s_and_b32 s41, s41, 15
    v_lshl_add_u32 v46, s41, 13, v49
    global_load_dwordx4 v[120:123], v46, s[10:11] nt
    s_add_u32 s41, s42, 15
    s_and_b32 s41, s41, 15
    v_lshl_add_u32 v47, s41, 13, v49
    global_load_dwordx4 v[124:127], v47, s[10:11] nt
    s_waitcnt vmcnt(18)
    s_branch Lnq2
Lnq:
    s_waitcnt vmcnt(0)
    s_cmp_lg_u32 s3, 1
    s_cbranch_scc1 Lop1
    s_cmp_eq_u32 s31, 0
    s_cbranch_scc1 Lop1
    s_lshr_b32 s40, s31, 3
    s_lshl_b32 s40, s40, 3
    s_add_u32 s40, s40, s30
    s_lshl_b32 s40, s40, 17
    s_and_b32 s41, s31, 7
    s_lshl_b32 s41, s41, 14
    s_add_u32 s40, s40, s41
    v_lshl_add_u32 v12, v0, 7, s40
    v_add_u32 v13, 0x2000, v12
    global_load_dword v58, v12, s[12:13]
    global_load_dword v58, v13, s[12:13]
    s_cmp_lg_u32 s31, 8
    s_cbranch_scc1 Lop1
    v_add_u32 v12, 0xfff00000, v12
    v_add_u32 v13, 0xfff00000, v13
    global_load_dword v58, v12, s[12:13]
    global_load_dword v58, v13, s[12:13]
Lop1:
Lnq2:
    s_barrier
    s_cmp_lg_u32 s31, 0
    s_cbranch_scc1 Lnl2
    s_cmp_lg_u32 s3, 1
    s_cbranch_scc1 Lnl2
    s_lshl_b32 s40, s30, 5
    v_mov_b32 v12, s40
    s_add_u32 s40, s48, 1
    v_mov_b32 v13, s40
    s_mov_b64 exec, 1
    global_store_dword v12, v13, s[24:25] sc1
    s_mov_b64 exec, -1
Lnl2:
    s_cmp_lg_u32 s3, 0
    s_cbranch_scc1 Lkv
    s_sub_u32 s33, s31, 1
    s_cselect_b32 s32, 3, 0
    s_cmp_lt_u32 s31, 17
    s_cbranch_scc1 Lrole1
    s_mul_i32 s33, s30, 11
    s_add_u32 s33, s33, s31
    s_sub_u32 s33, s33, 17
    s_cmp_lt_u32 s33, 86
    s_cselect_b32 s32, 1, 3
    s_cmp_lt_u32 s31, 28
    s_cbranch_scc1 Lrole1
    s_lshl_b32 s33, s30, 2
    s_add_u32 s33, s33, s31
    s_sub_u32 s33, s33, 28
    s_mov_b32 s32, 2
Lrole1:
    v_and_b32 v4, 15, v0
    v_and_b32 v5, 1, v0
    v_lshlrev_b32 v5, 4, v5
    v_mov_b32 v6, 0xffff
    v_lshlrev_b32 v5, v5, v6
    v_lshrrev_b32 v6, 1, v4
    v_cmp_eq_u32 vcc, 0, v6
    s_nop 1
    v_cndmask_b32 v60, 0, v5, vcc
    v_cmp_eq_u32 vcc, 1, v6
    s_nop 1
    v_cndmask_b32 v61, 0, v5, vcc
    v_cmp_eq_u32 vcc, 2, v6
    s_nop 1
    v_cndmask_b32 v62, 0, v5, vcc
    v_cmp_eq_u32 vcc, 3, v6
    s_nop 1
    v_cndmask_b32 v63, 0, v5, vcc
    s_lshl_b32 s36, s28, 3
    s_add_u32 s36, s36, s29
    s_lshl_b32 s37, s36, 11
    s_add_u32 s38, s26, s37
    s_addc_u32 s39, s27, 0
    s_waitcnt vmcnt(16)
    v_lshlrev_b32 v24, 16, v16
    v_and_b32 v25, 0xffff0000, v16
    v_lshlrev_b32 v26, 16, v17
    v_and_b32 v27, 0xffff0000, v17
    v_lshlrev_b32 v28, 16, v18
    v_and_b32 v29, 0xffff0000, v18
    v_lshlrev_b32 v30, 16, v19
    v_and_b32 v31, 0xffff0000, v19
    v_add_f32 v21, v24, v25
    v_add_f32 v21, v21, v26
    v_add_f32 v21, v21, v27
    v_add_f32 v21, v21, v28
    v_add_f32 v21, v21, v29
    v_add_f32 v21, v21, v30
    v_add_f32 v21, v21, v31
    s_nop 1
    v_add_f32_dpp v21, v21, v21 quad_perm:[1,0,3,2] row_mask:0xf bank_mask:0xf
    s_nop 1
    v_add_f32_dpp v21, v21, v21 quad_perm:[2,3,0,1] row_mask:0xf bank_mask:0xf
    s_nop 1
    v_add_f32_dpp v21, v21, v21 row_half_mirror row_mask:0xf bank_mask:0xf
    s_nop 1
    v_add_f32_dpp v21, v21, v21 row_mirror row_mask:0xf bank_mask:0xf
    s_nop 1
    v_add_f32_dpp v21, v21, v21 row_bcast:15 row_mask:0xa bank_mask:0xf
    s_nop 1
    v_add_f32_dpp v21, v21, v21 row_bcast:31 row_mask:0xc bank_mask:0xf
    s_nop 0
    v_readlane_b32 s40, v21, 63
    v_mov_b32 v22, 0x3b000000
    s_nop 0
    v_mul_f32 v23, s40, v22
    v_sub_f32 v24, v24, v23
    v_sub_f32 v25, v25, v23
    v_sub_f32 v26, v26, v23
    v_sub_f32 v27, v27, v23
    v_sub_f32 v28, v28, v23
    v_sub_f32 v29, v29, v23
    v_sub_f32 v30, v30, v23
    v_sub_f32 v31, v31, v23
    v_mul_f32 v21, v24, v24
    v_fmac_f32 v21, v25, v25
    v_fmac_f32 v21, v26, v26
    v_fmac_f32 v21, v27, v27
    v_fmac_f32 v21, v28, v28
    v_fmac_f32 v21, v29, v29
    v_fmac_f32 v21, v30, v30
    v_fmac_f32 v21, v31, v31
    s_nop 1
    v_add_f32_dpp v21, v21, v21 quad_perm:[1,0,3,2] row_mask:0xf bank_mask:0xf
    s_nop 1
    v_add_f32_dpp v21, v21, v21 quad_perm:[2,3,0,1] row_mask:0xf bank_mask:0xf
    s_nop 1
    v_add_f32_dpp v21, v21, v21 row_half_mirror row_mask:0xf bank_mask:0xf
    s_nop 1
    v_add_f32_dpp v21, v21, v21 row_mirror row_mask:0xf bank_mask:0xf
    s_nop 1
    v_add_f32_dpp v21, v21, v21 row_bcast:15 row_mask:0xa bank_mask:0xf
    s_nop 1
    v_add_f32_dpp v21, v21, v21 row_bcast:31 row_mask:0xc bank_mask:0xf
    s_nop 0
    v_readlane_b32 s40, v21, 63
    v_cvt_pk_bf16_f32 v23, v23, v23
    v_lshlrev_b32 v23, 16, v23
    v_mul_f32 v21, s40, v22
    v_cvt_pk_bf16_f32 v21, v21, v21
    v_lshlrev_b32 v21, 16, v21
    v_add_f32 v21, 0x3727c5ac, v21
    v_cvt_pk_bf16_f32 v21, v21, v21
    v_lshlrev_b32 v21, 16, v21
    v_sqrt_f32 v21, v21
    v_lshlrev_b32 v20, 16, v20
    v_cvt_pk_bf16_f32 v21, v21, v21
    v_lshlrev_b32 v21, 16, v21
    v_rcp_f32 v21, v21
    v_sub_f32 v20, v20, v23
    v_cvt_pk_bf16_f32 v20, v20, v20
    v_lshlrev_b32 v20, 16, v20
    v_mul_f32 v20, v20, v21
    v_cvt_pk_bf16_f32 v20, v20, v20
    s_nop 1
    v_and_b32_dpp v32, v20, v60 row_newbcast:0 row_mask:0xf bank_mask:0xf
    v_and_b32_dpp v33, v20, v61 row_newbcast:0 row_mask:0xf bank_mask:0xf
    v_and_b32_dpp v34, v20, v62 row_newbcast:0 row_mask:0xf bank_mask:0xf
    v_and_b32_dpp v35, v20, v63 row_newbcast:0 row_mask:0xf bank_mask:0xf
    s_waitcnt vmcnt(15)
    s_nop 0
    v_mfma_f32_16x16x32_bf16 v[8:11], v[32:35], v[64:67], 0
    v_and_b32_dpp v36, v20, v60 row_newbcast:1 row_mask:0xf bank_mask:0xf
    v_and_b32_dpp v37, v20, v61 row_newbcast:1 row_mask:0xf bank_mask:0xf
    v_and_b32_dpp v38, v20, v62 row_newbcast:1 row_mask:0xf bank_mask:0xf
    v_and_b32_dpp v39, v20, v63 row_newbcast:1 row_mask:0xf bank_mask:0xf
    s_waitcnt vmcnt(14)
    s_nop 0
    v_mfma_f32_16x16x32_bf16 v[8:11], v[36:39], v[68:71], v[8:11]
    v_and_b32_dpp v40, v20, v60 row_newbcast:2 row_mask:0xf bank_mask:0xf
    v_and_b32_dpp v41, v20, v61 row_newbcast:2 row_mask:0xf bank_mask:0xf
    v_and_b32_dpp v42, v20, v62 row_newbcast:2 row_mask:0xf bank_mask:0xf
    v_and_b32_dpp v43, v20, v63 row_newbcast:2 row_mask:0xf bank_mask:0xf
    s_waitcnt vmcnt(13)
    s_nop 0
    v_mfma_f32_16x16x32_bf16 v[8:11], v[40:43], v[72:75], v[8:11]
    v_and_b32_dpp v44, v20, v60 row_newbcast:3 row_mask:0xf bank_mask:0xf
    v_and_b32_dpp v45, v20, v61 row_newbcast:3 row_mask:0xf bank_mask:0xf
    v_and_b32_dpp v46, v20, v62 row_newbcast:3 row_mask:0xf bank_mask:0xf
    v_and_b32_dpp v47, v20, v63 row_newbcast:3 row_mask:0xf bank_mask:0xf
    s_waitcnt vmcnt(12)
    s_nop 0
    v_mfma_f32_16x16x32_bf16 v[8:11], v[44:47], v[76:79], v[8:11]
    v_and_b32_dpp v32, v20, v60 row_newbcast:4 row_mask:0xf bank_mask:0xf
    v_and_b32_dpp v33, v20, v61 row_newbcast:4 row_mask:0xf bank_mask:0xf
    v_and_b32_dpp v34, v20, v62 row_newbcast:4 row_mask:0xf bank_mask:0xf
    v_and_b32_dpp v35, v20, v63 row_newbcast:4 row_mask:0xf bank_mask:0xf
    s_waitcnt vmcnt(11)
    s_nop 0
    v_mfma_f32_16x16x32_bf16 v[8:11], v[32:35], v[80:83], v[8:11]
    v_and_b32_dpp v36, v20, v60 row_newbcast:5 row_mask:0xf bank_mask:0xf
    v_and_b32_dpp v37, v20, v61 row_newbcast:5 row_mask:0xf bank_mask:0xf
    v_and_b32_dpp v38, v20, v62 row_newbcast:5 row_mask:0xf bank_mask:0xf
    v_and_b32_dpp v39, v20, v63 row_newbcast:5 row_mask:0xf bank_mask:0xf
    s_waitcnt vmcnt(10)
    s_nop 0
    v_mfma_f32_16x16x32_bf16 v[8:11], v[36:39], v[84:87], v[8:11]
    v_and_b32_dpp v40, v20, v60 row_newbcast:6 row_mask:0xf bank_mask:0xf
    v_and_b32_dpp v41, v20, v61 row_newbcast:6 row_mask:0xf bank_mask:0xf
    v_and_b32_dpp v42, v20, v62 row_newbcast:6 row_mask:0xf bank_mask:0xf
    v_and_b32_dpp v43, v20, v63 row_newbcast:6 row_mask:0xf bank_mask:0xf
    s_waitcnt vmcnt(9)
    s_nop 0
    v_mfma_f32_16x16x32_bf16 v[8:11], v[40:43], v[88:91], v[8:11]
    v_and_b32_dpp v44, v20, v60 row_newbcast:7 row_mask:0xf bank_mask:0xf
    v_and_b32_dpp v45, v20, v61 row_newbcast:7 row_mask:0xf bank_mask:0xf
    v_and_b32_dpp v46, v20, v62 row_newbcast:7 row_mask:0xf bank_mask:0xf
    v_and_b32_dpp v47, v20, v63 row_newbcast:7 row_mask:0xf bank_mask:0xf
    s_waitcnt vmcnt(8)
    s_nop 0
    v_mfma_f32_16x16x32_bf16 v[8:11], v[44:47], v[92:95], v[8:11]
    v_and_b32_dpp v32, v20, v60 row_newbcast:8 row_mask:0xf bank_mask:0xf
    v_and_b32_dpp v33, v20, v61 row_newbcast:8 row_mask:0xf bank_mask:0xf
    v_and_b32_dpp v34, v20, v62 row_newbcast:8 row_mask:0xf bank_mask:0xf
    v_and_b32_dpp v35, v20, v63 row_newbcast:8 row_mask:0xf bank_mask:0xf
    s_waitcnt vmcnt(7)
    s_nop 0
    v_mfma_f32_16x16x32_bf16 v[8:11], v[32:35], v[96:99], v[8:11]
    v_and_b32_dpp v36, v20, v60 row_newbcast:9 row_mask:0xf bank_mask:0xf
    v_and_b32_dpp v37, v20, v61 row_newbcast:9 row_mask:0xf bank_mask:0xf
    v_and_b32_dpp v38, v20, v62 row_newbcast:9 row_mask:0xf bank_mask:0xf
    v_and_b32_dpp v39, v20, v63 row_newbcast:9 row_mask:0xf bank_mask:0xf
    s_waitcnt vmcnt(6)
    s_nop 0
    v_mfma_f32_16x16x32_bf16 v[8:11], v[36:39], v[100:103], v[8:11]
    v_and_b32_dpp v40, v20, v60 row_newbcast:10 row_mask:0xf bank_mask:0xf
    v_and_b32_dpp v41, v20, v61 row_newbcast:10 row_mask:0xf bank_mask:0xf
    v_and_b32_dpp v42, v20, v62 row_newbcast:10 row_mask:0xf bank_mask:0xf
    v_and_b32_dpp v43, v20, v63 row_newbcast:10 row_mask:0xf bank_mask:0xf
    s_waitcnt vmcnt(5)
    s_nop 0
    v_mfma_f32_16x16x32_bf16 v[8:11], v[40:43], v[104:107], v[8:11]
    v_and_b32_dpp v44, v20, v60 row_newbcast:11 row_mask:0xf bank_mask:0xf
    v_and_b32_dpp v45, v20, v61 row_newbcast:11 row_mask:0xf bank_mask:0xf
    v_and_b32_dpp v46, v20, v62 row_newbcast:11 row_mask:0xf bank_mask:0xf
    v_and_b32_dpp v47, v20, v63 row_newbcast:11 row_mask:0xf bank_mask:0xf
    s_waitcnt vmcnt(4)
    s_nop 0
    v_mfma_f32_16x16x32_bf16 v[8:11], v[44:47], v[108:111], v[8:11]
    v_and_b32_dpp v32, v20, v60 row_newbcast:12 row_mask:0xf bank_mask:0xf
    v_and_b32_dpp v33, v20, v61 row_newbcast:12 row_mask:0xf bank_mask:0xf
    v_and_b32_dpp v34, v20, v62 row_newbcast:12 row_mask:0xf bank_mask:0xf
    v_and_b32_dpp v35, v20, v63 row_newbcast:12 row_mask:0xf bank_mask:0xf
    s_waitcnt vmcnt(3)
    s_nop 0
    v_mfma_f32_16x16x32_bf16 v[8:11], v[32:35], v[112:115], v[8:11]
    v_and_b32_dpp v36, v20, v60 row_newbcast:13 row_mask:0xf bank_mask:0xf
    v_and_b32_dpp v37, v20, v61 row_newbcast:13 row_mask:0xf bank_mask:0xf
    v_and_b32_dpp v38, v20, v62 row_newbcast:13 row_mask:0xf bank_mask:0xf
    v_and_b32_dpp v39, v20, v63 row_newbcast:13 row_mask:0xf bank_mask:0xf
    s_waitcnt vmcnt(2)
    s_nop 0
    v_mfma_f32_16x16x32_bf16 v[8:11], v[36:39], v[116:119], v[8:11]
    v_and_b32_dpp v40, v20, v60 row_newbcast:14 row_mask:0xf bank_mask:0xf
    v_and_b32_dpp v41, v20, v61 row_newbcast:14 row_mask:0xf bank_mask:0xf
    v_and_b32_dpp v42, v20, v62 row_newbcast:14 row_mask:0xf bank_mask:0xf
    v_and_b32_dpp v43, v20, v63 row_newbcast:14 row_mask:0xf bank_mask:0xf
    s_waitcnt vmcnt(1)
    s_nop 0
    v_mfma_f32_16x16x32_bf16 v[8:11], v[40:43], v[120:123], v[8:11]
    v_and_b32_dpp v44, v20, v60 row_newbcast:15 row_mask:0xf bank_mask:0xf
    v_and_b32_dpp v45, v20, v61 row_newbcast:15 row_mask:0xf bank_mask:0xf
    v_and_b32_dpp v46, v20, v62 row_newbcast:15 row_mask:0xf bank_mask:0xf
    v_and_b32_dpp v47, v20, v63 row_newbcast:15 row_mask:0xf bank_mask:0xf
    s_waitcnt vmcnt(0)
    s_nop 0
    v_mfma_f32_16x16x32_bf16 v[8:11], v[44:47], v[124:127], v[8:11]
    v_lshrrev_b32 v12, 4, v0
    v_lshlrev_b32 v12, 4, v12
    v_lshl_add_u32 v12, v4, 5, v12
    s_nop 5
    v_and_or_b32 v8, v8, -16, s48
    v_min_u32 v8, -2, v8
    v_min_u32 v9, -2, v9
    v_min_u32 v10, -2, v10
    v_min_u32 v11, -2, v11
    s_and_b32 s40, s28, 7
    s_lshl_b32 s40, s40, 5
    v_mov_b32 v13, s40
    s_mov_b64 exec, 1
    s_mov_b64 exec, -1
    global_load_dwordx4 v[64:67], v1, s[6:7] offset:-4096 nt
    s_nop 0
    global_load_dwordx4 v[68:71], v1, s[6:7] offset:-3072 nt
    s_nop 0
    global_load_dwordx4 v[72:75], v1, s[6:7] offset:-2048 nt
    s_nop 0
    global_load_dwordx4 v[76:79], v1, s[6:7] offset:-1024 nt
    global_load_dword v42, v13, s[24:25] sc1
    s_nop 0
    global_load_dwordx4 v[80:83], v1, s[6:7] offset:0 nt
    s_nop 0
    global_load_dwordx4 v[84:87], v1, s[6:7] offset:1024 nt
    s_nop 0
    global_load_dwordx4 v[88:91], v1, s[6:7] offset:2048 nt
    s_nop 0
    global_load_dwordx4 v[92:95], v1, s[6:7] offset:3072 nt
    global_load_dword v43, v13, s[24:25] sc1
    s_nop 0
    global_load_dwordx4 v[96:99], v1, s[8:9] offset:-4096 nt
    s_nop 0
    global_load_dwordx4 v[100:103], v1, s[8:9] offset:-3072 nt
    s_nop 0
    global_load_dwordx4 v[104:107], v1, s[8:9] offset:-2048 nt
    s_nop 0
    global_load_dwordx4 v[108:111], v1, s[8:9] offset:-1024 nt
    global_load_dword v44, v13, s[24:25] sc1
    s_nop 0
    global_load_dwordx4 v[112:115], v1, s[8:9] offset:0 nt
    s_nop 0
    global_load_dwordx4 v[116:119], v1, s[8:9] offset:1024 nt
    s_nop 0
    global_load_dwordx4 v[120:123], v1, s[8:9] offset:2048 nt
    s_nop 0
    global_load_dwordx4 v[124:127], v1, s[8:9] offset:3072 nt
    global_load_dword v45, v13, s[24:25] sc1
    s_nop 0
    s_mov_b64 exec, 1
    s_waitcnt vmcnt(15)
    v_mov_b32 v14, v42
    v_cmp_eq_u32 vcc, 0, v14
    s_cbranch_vccz Lgod
    s_waitcnt vmcnt(10)
    v_mov_b32 v14, v43
    v_cmp_eq_u32 vcc, 0, v14
    s_cbranch_vccz Lgod
    s_waitcnt vmcnt(5)
    v_mov_b32 v14, v44
    v_cmp_eq_u32 vcc, 0, v14
    s_cbranch_vccz Lgod
    s_waitcnt vmcnt(0)
    v_mov_b32 v14, v45
    v_cmp_eq_u32 vcc, 0, v14
    s_cbranch_vccz Lgod
    s_mov_b32 s47, 0
Lgo:
    global_load_dword v14, v13, s[24:25] sc1
    s_waitcnt vmcnt(0)
    v_cmp_eq_u32 vcc, 0, v14
    s_add_u32 s47, s47, 1
    s_cbranch_vccz Lgod
    s_cmp_lt_u32 s47, 131072
    s_cbranch_scc1 Lgo
Lgod:
    v_readfirstlane_b32 s40, v14
    s_add_u32 s41, s48, 1
    s_mov_b64 exec, 0xffffffff
    s_cmp_eq_u32 s40, s41
    s_cselect_b32 s49, 1, 2
    s_cbranch_scc1 Lq1
    global_store_dwordx4 v12, v[8:11], s[38:39] sc1
    s_branch Lq2
Lq1:
    global_store_dwordx4 v12, v[8:11], s[38:39]
Lq2:
    s_mov_b64 exec, -1
    s_waitcnt vmcnt(1)
    s_lshl_b32 s40, s28, 14
    s_add_u32 s40, s26, s40
    s_addc_u32 s41, s27, 0
    v_lshrrev_b32 v13, 5, v0
    v_lshlrev_b32 v13, 11, v13
    v_and_b32 v14, 31, v0
    v_lshl_add_u32 v13, v14, 4, v13
    v_add_u32 v15, 0x1000, v13
    v_add_u32 v32, 0x2000, v13
    v_add_u32 v33, 0x3000, v13
    s_mov_b32 s47, 0
Lp0:
    global_load_dwordx4 v[16:19], v13, s[40:41] sc1
    global_load_dwordx4 v[20:23], v15, s[40:41] sc1
    global_load_dwordx4 v[24:27], v32, s[40:41] sc1
    global_load_dwordx4 v[28:31], v33, s[40:41] sc1
    s_waitcnt vmcnt(0)
    v_max3_u32 v3, v16, v17, v18
    v_max3_u32 v3, v3, v19, v20
    v_max3_u32 v3, v3, v21, v22
    v_max3_u32 v3, v3, v23, v24
    v_max3_u32 v3, v3, v25, v26
    v_max3_u32 v3, v3, v27, v28
    v_max3_u32 v3, v3, v29, v30
    v_max_u32 v3, v3, v31
    v_cmpx_eq_u32 vcc, -1, v3
    s_add_u32 s47, s47, 1
    s_cbranch_execz Lp0d
    s_cmp_lt_u32 s47, 131072
    s_cbranch_scc1 Lp0
Lp0d:
    s_mov_b64 exec, -1
    s_nop 1
    v_xor_b32 v34, s48, v16
    v_xor_b32 v35, s48, v20
    v_xor_b32 v36, s48, v24
    v_xor_b32 v37, s48, v28
    v_add_f32 v16, v16, v20
    v_add_f32 v24, v24, v28
    v_add_f32 v17, v17, v21
    v_add_f32 v25, v25, v29
    v_add_f32 v18, v18, v22
    v_add_f32 v26, v26, v30
    v_add_f32 v19, v19, v23
    v_add_f32 v27, v27, v31
    v_add_f32 v16, v16, v24
    v_add_f32 v17, v17, v25
    v_add_f32 v18, v18, v26
    v_add_f32 v19, v19, v27
    v_mov_b32 v20, v16
    v_mov_b32 v21, v17
    v_mov_b32 v22, v18
    v_mov_b32 v23, v19
    s_nop 0
    v_permlane32_swap_b32 v16, v20
    v_permlane32_swap_b32 v17, v21
    v_permlane32_swap_b32 v18, v22
    v_permlane32_swap_b32 v19, v23
    s_nop 0
    v_add_f32 v16, v16, v20
    v_add_f32 v17, v17, v21
    v_add_f32 v18, v18, v22
    v_add_f32 v19, v19, v23
    v_cvt_pk_bf16_f32 v16, v16, v17
    v_cvt_pk_bf16_f32 v17, v18, v19
    v_lshlrev_b32 v14, 3, v14
    v_mov_b32 v18, s49
    ds_write_b64 v14, v[16:17] offset:0
    s_waitcnt lgkmcnt(0)
    ds_write_b32 v2, v18 offset:256
    v_or3_b32 v34, v34, v35, v36
    v_or_b32 v34, v34, v37
    v_and_b32 v34, 15, v34
    v_cmp_ne_u32 vcc, 0, v34
    s_cbranch_vccz Lq3
    s_mov_b64 exec, 0xffffffff
    global_store_dwordx4 v12, v[8:11], s[38:39] sc1
    s_waitcnt vmcnt(0)
    s_mov_b64 exec, -1
Lq3:
    s_setprio 1
    s_branch Lkvd
Lkv:
    s_setprio 1
    global_load_dwordx4 v[64:67], v1, s[6:7] offset:-4096 nt
    s_nop 0
    global_load_dwordx4 v[68:71], v1, s[6:7] offset:-3072 nt
    s_nop 0
    global_load_dwordx4 v[72:75], v1, s[6:7] offset:-2048 nt
    s_nop 0
    global_load_dwordx4 v[76:79], v1, s[6:7] offset:-1024 nt
    s_nop 0
    global_load_dwordx4 v[80:83], v1, s[6:7] offset:0 nt
    s_nop 0
    global_load_dwordx4 v[84:87], v1, s[6:7] offset:1024 nt
    s_nop 0
    global_load_dwordx4 v[88:91], v1, s[6:7] offset:2048 nt
    s_nop 0
    global_load_dwordx4 v[92:95], v1, s[6:7] offset:3072 nt
    s_nop 0
    global_load_dwordx4 v[96:99], v1, s[8:9] offset:-4096 nt
    s_nop 0
    global_load_dwordx4 v[100:103], v1, s[8:9] offset:-3072 nt
    s_nop 0
    global_load_dwordx4 v[104:107], v1, s[8:9] offset:-2048 nt
    s_nop 0
    global_load_dwordx4 v[108:111], v1, s[8:9] offset:-1024 nt
    s_nop 0
    global_load_dwordx4 v[112:115], v1, s[8:9] offset:0 nt
    s_nop 0
    global_load_dwordx4 v[116:119], v1, s[8:9] offset:1024 nt
    s_nop 0
    global_load_dwordx4 v[120:123], v1, s[8:9] offset:2048 nt
    s_nop 0
    global_load_dwordx4 v[124:127], v1, s[8:9] offset:3072 nt
    s_nop 0
    s_sub_u32 s33, s31, 1
    s_cselect_b32 s32, 3, 0
    s_cmp_lt_u32 s31, 17
    s_cbranch_scc1 Lrole2
    s_mul_i32 s33, s30, 11
    s_add_u32 s33, s33, s31
    s_sub_u32 s33, s33, 17
    s_cmp_lt_u32 s33, 86
    s_cselect_b32 s32, 1, 3
    s_cmp_lt_u32 s31, 28
    s_cbranch_scc1 Lrole2
    s_lshl_b32 s33, s30, 2
    s_add_u32 s33, s33, s31
    s_sub_u32 s33, s33, 28
    s_mov_b32 s32, 2
Lrole2:
    v_and_b32 v4, 15, v0
    v_and_b32 v5, 1, v0
    v_lshlrev_b32 v5, 4, v5
    v_mov_b32 v6, 0xffff
    v_lshlrev_b32 v5, v5, v6
    v_lshrrev_b32 v6, 1, v4
    v_cmp_eq_u32 vcc, 0, v6
    s_nop 1
    v_cndmask_b32 v60, 0, v5, vcc
    v_cmp_eq_u32 vcc, 1, v6
    s_nop 1
    v_cndmask_b32 v61, 0, v5, vcc
    v_cmp_eq_u32 vcc, 2, v6
    s_nop 1
    v_cndmask_b32 v62, 0, v5, vcc
    v_cmp_eq_u32 vcc, 3, v6
    s_nop 1
    v_cndmask_b32 v63, 0, v5, vcc
    s_lshl_b32 s36, s28, 3
    s_add_u32 s36, s36, s29
    s_lshl_b32 s37, s36, 11
    s_add_u32 s38, s26, s37
    s_addc_u32 s39, s27, 0
Lkvd:
    s_mov_b32 s47, 0
Lq:
    ds_read_b32 v3, v2 offset:256
    s_waitcnt lgkmcnt(0)
    v_readfirstlane_b32 s49, v3
    s_add_u32 s47, s47, 1
    s_cmp_lg_u32 s49, 0
    s_cbranch_scc1 Lqd
    s_cmp_lt_u32 s47, 1048576
    s_cbranch_scc1 Lq
Lqd:
    v_lshlrev_b32 v3, 4, v4
    ds_read_b128 v[8:11], v3 offset:0
    s_waitcnt lgkmcnt(0)
    s_waitcnt vmcnt(15)
    v_dot2_f32_bf16 v16, v64, v8, 0
    v_dot2_f32_bf16 v16, v65, v9, v16
    v_dot2_f32_bf16 v16, v66, v10, v16
    v_dot2_f32_bf16 v16, v67, v11, v16
    s_waitcnt vmcnt(14)
    v_dot2_f32_bf16 v17, v68, v8, 0
    v_dot2_f32_bf16 v17, v69, v9, v17
    v_dot2_f32_bf16 v17, v70, v10, v17
    v_dot2_f32_bf16 v17, v71, v11, v17
    s_waitcnt vmcnt(13)
    v_dot2_f32_bf16 v18, v72, v8, 0
    v_dot2_f32_bf16 v18, v73, v9, v18
    v_dot2_f32_bf16 v18, v74, v10, v18
    v_dot2_f32_bf16 v18, v75, v11, v18
    s_waitcnt vmcnt(12)
    v_dot2_f32_bf16 v19, v76, v8, 0
    v_dot2_f32_bf16 v19, v77, v9, v19
    v_dot2_f32_bf16 v19, v78, v10, v19
    v_dot2_f32_bf16 v19, v79, v11, v19
    s_waitcnt vmcnt(11)
    v_dot2_f32_bf16 v20, v80, v8, 0
    v_dot2_f32_bf16 v20, v81, v9, v20
    v_dot2_f32_bf16 v20, v82, v10, v20
    v_dot2_f32_bf16 v20, v83, v11, v20
    s_waitcnt vmcnt(10)
    v_dot2_f32_bf16 v21, v84, v8, 0
    v_dot2_f32_bf16 v21, v85, v9, v21
    v_dot2_f32_bf16 v21, v86, v10, v21
    v_dot2_f32_bf16 v21, v87, v11, v21
    s_waitcnt vmcnt(9)
    v_dot2_f32_bf16 v22, v88, v8, 0
    v_dot2_f32_bf16 v22, v89, v9, v22
    v_dot2_f32_bf16 v22, v90, v10, v22
    v_dot2_f32_bf16 v22, v91, v11, v22
    s_waitcnt vmcnt(8)
    v_dot2_f32_bf16 v23, v92, v8, 0
    v_dot2_f32_bf16 v23, v93, v9, v23
    v_dot2_f32_bf16 v23, v94, v10, v23
    v_dot2_f32_bf16 v23, v95, v11, v23
    s_nop 2
    v_add_f32_dpp v16, v16, v16 row_ror:8 row_mask:0xf bank_mask:0x3
    v_add_f32_dpp v18, v18, v18 row_ror:8 row_mask:0xf bank_mask:0x3
    v_add_f32_dpp v20, v20, v20 row_ror:8 row_mask:0xf bank_mask:0x3
    v_add_f32_dpp v22, v22, v22 row_ror:8 row_mask:0xf bank_mask:0x3
    v_add_f32_dpp v16, v17, v17 row_ror:8 row_mask:0xf bank_mask:0xc
    v_add_f32_dpp v18, v19, v19 row_ror:8 row_mask:0xf bank_mask:0xc
    v_add_f32_dpp v20, v21, v21 row_ror:8 row_mask:0xf bank_mask:0xc
    v_add_f32_dpp v22, v23, v23 row_ror:8 row_mask:0xf bank_mask:0xc
    s_nop 0
    v_add_f32_dpp v16, v16, v16 row_half_mirror row_mask:0xf bank_mask:0x5
    v_add_f32_dpp v20, v20, v20 row_half_mirror row_mask:0xf bank_mask:0x5
    v_add_f32_dpp v16, v18, v18 row_half_mirror row_mask:0xf bank_mask:0xa
    v_add_f32_dpp v20, v22, v22 row_half_mirror row_mask:0xf bank_mask:0xa
    s_nop 0
    v_add_f32_dpp v16, v16, v16 quad_perm:[1,0,3,2] row_mask:0xf bank_mask:0xf
    v_add_f32_dpp v20, v20, v20 quad_perm:[1,0,3,2] row_mask:0xf bank_mask:0xf
    s_nop 0
    v_add_f32_dpp v16, v16, v16 quad_perm:[2,3,0,1] row_mask:0xf bank_mask:0xf
    v_add_f32_dpp v20, v20, v20 quad_perm:[2,3,0,1] row_mask:0xf bank_mask:0xf
    v_cvt_pk_bf16_f32 v17, v16, v20
    v_lshlrev_b32 v16, 16, v17
    v_and_b32 v20, 0xffff0000, v17
    v_mul_f32 v16, 0x3db504f3, v16
    v_mul_f32 v20, 0x3db504f3, v20
    v_cvt_pk_bf16_f32 v17, v16, v20
    v_lshlrev_b32 v16, 16, v17
    v_and_b32 v20, 0xffff0000, v17
    v_mul_f32 v16, 0x3fb8aa3b, v16
    v_mul_f32 v20, 0x3fb8aa3b, v20
    v_max_f32 v17, v16, v20
    s_nop 1
    v_max_f32_dpp v17, v17, v17 row_ror:4 row_mask:0xf bank_mask:0xf
    s_nop 1
    v_max_f32_dpp v17, v17, v17 row_ror:8 row_mask:0xf bank_mask:0xf
    s_nop 1
    v_max_f32_dpp v17, v17, v17 row_bcast:15 row_mask:0xa bank_mask:0xf
    s_nop 1
    v_max_f32_dpp v17, v17, v17 row_bcast:31 row_mask:0xc bank_mask:0xf
    s_nop 0
    v_readlane_b32 s40, v17, 63
    s_nop 1
    v_subrev_f32 v16, s40, v16
    v_subrev_f32 v20, s40, v20
    v_exp_f32 v16, v16
    v_exp_f32 v20, v20
    v_mov_b32 v22, s40
    v_add_f32 v23, v16, v20
    v_cvt_pk_bf16_f32 v16, v16, v16
    v_cvt_pk_bf16_f32 v20, v20, v20
    s_nop 1
    v_add_f32_dpp v23, v23, v23 row_ror:4 row_mask:0xf bank_mask:0xf
    s_nop 1
    v_add_f32_dpp v23, v23, v23 row_ror:8 row_mask:0xf bank_mask:0xf
    s_nop 1
    v_add_f32_dpp v23, v23, v23 row_bcast:15 row_mask:0xa bank_mask:0xf
    s_nop 1
    v_add_f32_dpp v23, v23, v23 row_bcast:31 row_mask:0xc bank_mask:0xf
    s_nop 0
    v_readlane_b32 s41, v23, 63
    v_and_b32_dpp v64, v16, v60 row_newbcast:0 row_mask:0xf bank_mask:0xf
    v_and_b32_dpp v65, v16, v61 row_newbcast:0 row_mask:0xf bank_mask:0xf
    v_and_b32_dpp v66, v16, v62 row_newbcast:0 row_mask:0xf bank_mask:0xf
    v_and_b32_dpp v67, v16, v63 row_newbcast:0 row_mask:0xf bank_mask:0xf
    v_and_b32_dpp v68, v16, v60 row_newbcast:8 row_mask:0xf bank_mask:0xf
    v_and_b32_dpp v69, v16, v61 row_newbcast:8 row_mask:0xf bank_mask:0xf
    v_and_b32_dpp v70, v16, v62 row_newbcast:8 row_mask:0xf bank_mask:0xf
    v_and_b32_dpp v71, v16, v63 row_newbcast:8 row_mask:0xf bank_mask:0xf
    v_and_b32_dpp v72, v16, v60 row_newbcast:4 row_mask:0xf bank_mask:0xf
    v_and_b32_dpp v73, v16, v61 row_newbcast:4 row_mask:0xf bank_mask:0xf
    v_and_b32_dpp v74, v16, v62 row_newbcast:4 row_mask:0xf bank_mask:0xf
    v_and_b32_dpp v75, v16, v63 row_newbcast:4 row_mask:0xf bank_mask:0xf
    v_and_b32_dpp v76, v16, v60 row_newbcast:12 row_mask:0xf bank_mask:0xf
    v_and_b32_dpp v77, v16, v61 row_newbcast:12 row_mask:0xf bank_mask:0xf
    v_and_b32_dpp v78, v16, v62 row_newbcast:12 row_mask:0xf bank_mask:0xf
    v_and_b32_dpp v79, v16, v63 row_newbcast:12 row_mask:0xf bank_mask:0xf
    v_and_b32_dpp v80, v20, v60 row_newbcast:0 row_mask:0xf bank_mask:0xf
    v_and_b32_dpp v81, v20, v61 row_newbcast:0 row_mask:0xf bank_mask:0xf
    v_and_b32_dpp v82, v20, v62 row_newbcast:0 row_mask:0xf bank_mask:0xf
    v_and_b32_dpp v83, v20, v63 row_newbcast:0 row_mask:0xf bank_mask:0xf
    v_and_b32_dpp v84, v20, v60 row_newbcast:8 row_mask:0xf bank_mask:0xf
    v_and_b32_dpp v85, v20, v61 row_newbcast:8 row_mask:0xf bank_mask:0xf
    v_and_b32_dpp v86, v20, v62 row_newbcast:8 row_mask:0xf bank_mask:0xf
    v_and_b32_dpp v87, v20, v63 row_newbcast:8 row_mask:0xf bank_mask:0xf
    v_and_b32_dpp v88, v20, v60 row_newbcast:4 row_mask:0xf bank_mask:0xf
    v_and_b32_dpp v89, v20, v61 row_newbcast:4 row_mask:0xf bank_mask:0xf
    v_and_b32_dpp v90, v20, v62 row_newbcast:4 row_mask:0xf bank_mask:0xf
    v_and_b32_dpp v91, v20, v63 row_newbcast:4 row_mask:0xf bank_mask:0xf
    v_and_b32_dpp v92, v20, v60 row_newbcast:12 row_mask:0xf bank_mask:0xf
    v_and_b32_dpp v93, v20, v61 row_newbcast:12 row_mask:0xf bank_mask:0xf
    v_and_b32_dpp v94, v20, v62 row_newbcast:12 row_mask:0xf bank_mask:0xf
    v_and_b32_dpp v95, v20, v63 row_newbcast:12 row_mask:0xf bank_mask:0xf
    v_mov_b32 v23, s41
    s_lshl_b32 s40, s3, 3
    v_mov_b32 v3, s40
    ds_write_b64 v3, v[22:23] offset:384
    s_mul_i32 s40, s3, 528
    v_lshrrev_b32 v3, 4, v0
    v_lshlrev_b32 v3, 4, v3
    v_lshl_add_u32 v3, v4, 5, v3
    v_add_u32 v3, s40, v3
    s_waitcnt vmcnt(7)
    v_mfma_f32_16x16x32_bf16 v[8:11], v[64:67], v[96:99], 0
    s_waitcnt vmcnt(6)
    v_mfma_f32_16x16x32_bf16 v[8:11], v[68:71], v[100:103], v[8:11]
    s_waitcnt vmcnt(5)
    v_mfma_f32_16x16x32_bf16 v[8:11], v[72:75], v[104:107], v[8:11]
    s_waitcnt vmcnt(4)
    v_mfma_f32_16x16x32_bf16 v[8:11], v[76:79], v[108:111], v[8:11]
    s_waitcnt vmcnt(3)
    v_mfma_f32_16x16x32_bf16 v[8:11], v[80:83], v[112:115], v[8:11]
    s_waitcnt vmcnt(2)
    v_mfma_f32_16x16x32_bf16 v[8:11], v[84:87], v[116:119], v[8:11]
    s_waitcnt vmcnt(1)
    v_mfma_f32_16x16x32_bf16 v[8:11], v[88:91], v[120:123], v[8:11]
    s_waitcnt vmcnt(0)
    v_mfma_f32_16x16x32_bf16 v[8:11], v[92:95], v[124:127], v[8:11]
    s_mov_b64 exec, 0xffffffff
    s_nop 6
    ds_write_b128 v3, v[8:11] offset:512
    s_mov_b64 exec, -1
    s_cmp_ge_u32 s3, 8
    s_cbranch_scc1 Lcomb
    s_cmp_lg_u32 s3, 2
    s_cbranch_scc1 Lga
    v_and_b32 v13, 7, v0
    v_lshlrev_b32 v13, 5, v13
    v_add_u32 v12, 1, v4
    v_and_b32 v15, 3, v12
    v_lshl_add_u32 v15, v15, 3, s30
    v_lshrrev_b32 v12, 2, v12
    v_lshl_add_u32 v12, v15, 3, v12
    v_lshlrev_b32 v12, 11, v12
    s_cmp_eq_u32 s49, 1
    s_cbranch_scc1 Lg7
    v_mov_b32 v12, s37
    s_mov_b32 s48, -1
Lg7:
    s_mov_b64 exec, 0xffff
    s_mov_b32 s47, 0
Lg8:
    global_load_dword v14, v13, s[24:25] sc1
    global_load_dword v15, v12, s[26:27] sc1
    s_waitcnt vmcnt(0)
    v_add_u32 v14, -1, v14
    v_max_u32 v14, v14, v15
    v_cmp_eq_u32 vcc, -1, v14
    s_add_u32 s47, s47, 1
    s_cbranch_vccz Lg8d
    s_cmp_lt_u32 s47, 131072
    s_cbranch_scc1 Lg8
Lg8d:
    v_and_b32 v15, 15, v15
    v_cmp_ne_u32 vcc, s48, v15
    s_nop 4
    v_mov_b32 v14, vcc_lo
    ds_write_b32 v2, v14 offset:260
    s_mov_b64 exec, -1
Lga:
Lwd:
    s_setprio 1
    s_waitcnt lgkmcnt(0)
    s_barrier
    s_branch Lb2
Lcomb:
    s_and_b32 s40, s3, 3
    s_lshl_b32 s40, s40, 7
    v_mul_u32_u24 v12, 528, v4
    v_lshrrev_b32 v13, 4, v0
    v_lshl_add_u32 v13, v13, 5, s40
    v_add_u32 v12, v12, v13
    v_lshlrev_b32 v14, 3, v4
    v_lshl_add_u32 v13, v0, 1, s40
    v_bfe_u32 v15, v0, 2, 1
    v_lshlrev_b32 v15, 1, v15
    v_add_u32 v28, 0x07060500, v15
    v_add_u32 v29, 1, v28
    s_mov_b32 s42, 0x11111111
    s_mov_b32 s43, s42
    s_cmp_ge_u32 s3, 12
    s_waitcnt lgkmcnt(0)
    s_barrier
    s_cbranch_scc1 Lb2
    ds_read_b64 v[20:21], v14 offset:384
    ds_read_b128 v[16:19], v12 offset:512
    ds_read_b128 v[24:27], v12 offset:528
    ds_read_b32 v30, v2 offset:260
    s_waitcnt lgkmcnt(3)
    v_max_f32_dpp v22, v20, v20 quad_perm:[1,0,3,2] row_mask:0xf bank_mask:0xf
    s_nop 1
    v_max_f32_dpp v22, v22, v22 quad_perm:[2,3,0,1] row_mask:0xf bank_mask:0xf
    s_nop 1
    v_max_f32_dpp v22, v22, v22 row_half_mirror row_mask:0xf bank_mask:0xf
    s_nop 1
    v_max_f32_dpp v22, v22, v22 row_mirror row_mask:0xf bank_mask:0xf
    v_sub_f32 v20, v20, v22
    v_exp_f32 v20, v20
    s_waitcnt lgkmcnt(0)
    v_mul_f32 v21, v21, v20
    v_cmp_ne_u32 vcc, 0, v30
    v_mul_f32 v16, v16, v20
    v_mul_f32 v17, v17, v20
    v_mul_f32 v18, v18, v20
    v_mul_f32 v19, v19, v20
    v_add_f32_dpp v21, v21, v21 quad_perm:[1,0,3,2] row_mask:0xf bank_mask:0xf
    v_mul_f32 v24, v24, v20
    v_mul_f32 v25, v25, v20
    v_mul_f32 v26, v26, v20
    v_mul_f32 v27, v27, v20
    v_add_f32_dpp v21, v21, v21 quad_perm:[2,3,0,1] row_mask:0xf bank_mask:0xf
    v_add_f32_dpp v16, v16, v16 row_ror:8 row_mask:0xf bank_mask:0x3
    v_add_f32_dpp v17, v17, v17 row_ror:8 row_mask:0xf bank_mask:0x3
    v_add_f32_dpp v18, v18, v18 row_ror:8 row_mask:0xf bank_mask:0x3
    v_add_f32_dpp v19, v19, v19 row_ror:8 row_mask:0xf bank_mask:0x3
    v_add_f32_dpp v21, v21, v21 row_half_mirror row_mask:0xf bank_mask:0xf
    v_add_f32_dpp v16, v24, v24 row_ror:8 row_mask:0xf bank_mask:0xc
    v_add_f32_dpp v17, v25, v25 row_ror:8 row_mask:0xf bank_mask:0xc
    v_add_f32_dpp v18, v26, v26 row_ror:8 row_mask:0xf bank_mask:0xc
    v_add_f32_dpp v19, v27, v27 row_ror:8 row_mask:0xf bank_mask:0xc
    v_add_f32_dpp v21, v21, v21 row_mirror row_mask:0xf bank_mask:0xf
    v_add_f32_dpp v16, v16, v16 row_half_mirror row_mask:0xf bank_mask:0x5
    v_add_f32_dpp v17, v17, v17 row_half_mirror row_mask:0xf bank_mask:0x5
    v_add_f32_dpp v16, v18, v18 row_half_mirror row_mask:0xf bank_mask:0xa
    v_add_f32_dpp v17, v19, v19 row_half_mirror row_mask:0xf bank_mask:0xa
    v_log_f32 v20, v21
    v_add_f32_dpp v16, v16, v16 quad_perm:[1,0,3,2] row_mask:0xf bank_mask:0xf
    v_add_f32_dpp v17, v17, v17 quad_perm:[1,0,3,2] row_mask:0xf bank_mask:0xf
    v_rcp_f32 v21, v21
    v_add_f32_dpp v16, v16, v16 quad_perm:[2,3,0,1] row_mask:0xf bank_mask:0xf
    v_add_f32_dpp v17, v17, v17 quad_perm:[2,3,0,1] row_mask:0xf bank_mask:0xf
    v_add_f32 v20, v20, v22
    v_mul_f32 v16, v16, v21
    v_mul_f32 v17, v17, v21
    v_perm_b32 v16, v16, v20, v28
    v_perm_b32 v17, v17, v20, v29
    v_min_u32 v16, -2, v16
    v_min_u32 v17, -2, v17
    s_mov_b64 exec, s[42:43]
    s_cbranch_vccz Lc1
    global_store_dwordx2 v13, v[16:17], s[38:39] offset:512 sc1
    s_branch Lc2
Lc1:
    global_store_dwordx2 v13, v[16:17], s[38:39] offset:512
Lc2:
    s_mov_b64 exec, -1
Lb2:
    s_cmp_eq_u32 s32, 3
    s_cbranch_scc1 Lfin
    s_barrier
    s_mul_i32 s46, s3, 3072
    s_add_u32 s46, s46, 16384
    v_lshrrev_b32 v5, 4, v0
    v_and_b32 v6, 7, v0
    v_bfe_u32 v7, v0, 3, 1
    s_cmp_eq_u32 s32, 1
    s_cbranch_scc1 LB
    s_cmp_eq_u32 s32, 2
    s_cbranch_scc1 LC
    s_lshr_b32 s40, s3, 2
    s_lshl_b32 s40, s40, 3
    s_add_u32 s40, s40, s30
    s_lshl_b32 s40, s40, 17
    s_and_b32 s41, s3, 3
    s_lshl_b32 s41, s41, 15
    s_add_u32 s40, s40, s41
    s_lshl_b32 s41, s33, 6
    s_add_u32 s40, s40, s41
    v_lshrrev_b32 v12, 2, v0
    v_lshlrev_b32 v12, 10, v12
    v_and_b32 v13, 0x30, v1
    v_add3_u32 v12, v12, v13, s40
    v_add_u32 v13, 0x4000, v12
    v_add_u32 v14, 0x200000, v12
    v_add_u32 v15, 0x204000, v12
    s_add_u32 m0, s46, 0
    s_nop 0
    global_load_lds_dwordx4 v12, s[12:13]
    s_add_u32 m0, s46, 1024
    s_nop 0
    global_load_lds_dwordx4 v13, s[12:13]
    v_bfe_u32 v13, v0, 2, 2
    v_lshl_add_u32 v12, v13, 2, v5
    v_sub_u32 v13, 7, v13
    v_lshl_add_u32 v13, v13, 2, v5
    v_and_b32 v14, 3, v0
    v_lshl_add_u32 v14, v14, 3, s46
    v_lshl_add_u32 v12, v12, 6, v14
    v_lshl_add_u32 v13, v13, 6, v14
    v_mov_b32 v52, v12
    v_mov_b32 v53, v13
    s_lshr_b32 s40, s3, 2
    s_lshl_b32 s40, s40, 3
    s_add_u32 s40, s40, s30
    s_lshl_b32 s40, s40, 14
    s_add_u32 s40, s26, s40
    s_addc_u32 s41, s27, 0
    s_and_b32 s42, s3, 3
    s_lshl_b32 s42, s42, 7
    v_lshrrev_b32 v13, 3, v0
    v_lshlrev_b32 v13, 11, v13
    v_lshl_add_u32 v14, v6, 4, v13
    v_add_u32 v14, s42, v14
    s_lshl_b32 s42, s3, 2
    v_mul_u32_u24 v15, 80, v4
    v_add_u32 v15, s42, v15
    s_mov_b32 s44, 0x0c0c0400
    s_mov_b32 s45, 0x04000c0c
    s_mov_b32 s47, 0
Lp1:
    global_load_dwordx4 v[16:19], v14, s[40:41] offset:512 sc1
    s_waitcnt vmcnt(0)
    v_max3_u32 v3, v16, v17, v18
    v_max_u32 v3, v3, v19
    v_cmpx_eq_u32 vcc, -1, v3
    s_add_u32 s47, s47, 1
    s_cbranch_execz Lp1d
    s_cmp_lt_u32 s47, 131072
    s_cbranch_scc1 Lp1
Lp1d:
    s_mov_b64 exec, -1
    s_nop 1
    ds_read_b64_tr_b16 v[32:33], v52 offset:0
    ds_read_b64_tr_b16 v[34:35], v53 offset:0
    ds_read_b64_tr_b16 v[36:37], v52 offset:32
    ds_read_b64_tr_b16 v[38:39], v53 offset:32
    v_perm_b32 v20, v17, v16, s44
    v_perm_b32 v21, v19, v18, s45
    v_or_b32 v20, v20, v21
    s_nop 1
    v_max_f32_dpp v21, v20, v20 row_ror:8 row_mask:0xf bank_mask:0xf
    s_nop 1
    v_max_f32_dpp v21, v21, v21 row_bcast:15 row_mask:0xa bank_mask:0xf
    s_nop 1
    v_max_f32_dpp v21, v21, v21 row_bcast:31 row_mask:0xc bank_mask:0xf
    s_nop 0
    v_readlane_b32 s42, v21, 63
    s_nop 1
    v_subrev_f32 v20, s42, v20
    v_exp_f32 v20, v20
    s_nop 0
    v_mul_f32 v16, v16, v20
    v_mul_f32 v17, v17, v20
    v_mul_f32 v18, v18, v20
    v_mul_f32 v19, v19, v20
    v_add_f32_dpp v20, v20, v20 row_ror:8 row_mask:0xf bank_mask:0xf
    v_permlane16_swap_b32 v16, v17
    v_permlane16_swap_b32 v18, v19
    v_add_f32_dpp v20, v20, v20 row_bcast:15 row_mask:0xa bank_mask:0xf
    v_add_f32 v16, v16, v17
    v_add_f32 v18, v18, v19
    v_add_f32_dpp v20, v20, v20 row_bcast:31 row_mask:0xc bank_mask:0xf
    s_nop 0
    v_permlane32_swap_b32 v16, v18
    v_rcp_f32 v20, v20
    v_add_f32 v16, v16, v18
    s_nop 0
    v_readlane_b32 s42, v20, 63
    v_add_f32_dpp v16, v16, v16 row_ror:8 row_mask:0xf bank_mask:0xf
    s_nop 0
    v_mul_f32 v16, s42, v16
    s_nop 1
    v_mov_b32_dpp v17, v16 quad_perm:[1,0,3,2] row_mask:0xf bank_mask:0xf
    v_cvt_pk_bf16_f32 v24, v16, v17
    s_nop 1
    v_mov_b32_dpp v25, v24 quad_perm:[2,3,0,1] row_mask:0xf bank_mask:0xf
    v_mov_b32_dpp v26, v24 row_half_mirror row_mask:0xf bank_mask:0xf
    s_nop 0
    v_mov_b32_dpp v27, v25 row_half_mirror row_mask:0xf bank_mask:0xf
    s_waitcnt lgkmcnt(0)
    s_nop 0
    v_mfma_f32_16x16x32_bf16 v[8:11], v[24:27], v[32:35], 0
    v_mfma_f32_16x16x32_bf16 v[28:31], v[24:27], v[36:39], 0
    s_mov_b64 exec, 0xffff
    s_nop 5
    ds_write_b32 v15, v8 offset:9216
    ds_write_b32 v15, v28 offset:10496
    s_mov_b64 exec, -1
    v_lshrrev_b32 v12, 1, v0
    v_mul_u32_u24 v13, 80, v12
    v_and_b32 v14, 1, v0
    v_lshl_add_u32 v13, v14, 5, v13
    s_lshl_b32 s40, s30, 11
    s_lshl_b32 s41, s33, 7
    s_add_u32 s40, s40, s41
    s_add_u32 s40, s40, 524288
    v_lshl_add_u32 v12, v12, 2, s40
    s_waitcnt lgkmcnt(0)
    s_barrier
    s_cmp_lg_u32 s3, 0
    s_cbranch_scc1 Lfin
    ds_read_b128 v[16:19], v13 offset:9216
    ds_read_b128 v[20:23], v13 offset:9232
    s_mov_b32 s42, 0x55555555
    s_mov_b32 s43, s42
    s_waitcnt lgkmcnt(0)
    v_pk_add_f32 v[16:17], v[16:17], v[18:19]
    v_pk_add_f32 v[20:21], v[20:21], v[22:23]
    v_pk_add_f32 v[16:17], v[16:17], v[20:21]
    v_add_f32 v16, v16, v17
    s_nop 1
    v_add_f32_dpp v16, v16, v16 quad_perm:[1,0,3,2] row_mask:0xf bank_mask:0xf
    v_min_u32 v16, -2, v16
    s_mov_b64 exec, s[42:43]
    global_store_dword v12, v16, s[26:27] sc1
    s_mov_b64 exec, -1
    s_branch Lfin
LB:
    s_lshl_b32 s43, s33, 2
    s_add_u32 s43, s43, s3
    s_and_b32 s43, s43, 15
    s_mul_i32 s40, s43, 88064
    s_lshl_b32 s41, s33, 5
    s_add_u32 s40, s40, s41
    v_lshrrev_b32 v12, 1, v0
    v_mul_u32_u24 v12, 2752, v12
    v_and_b32 v13, 0x10, v1
    v_add3_u32 v12, v12, v13, s40
    s_lshl_b32 s42, s43, 6
    v_lshlrev_b32 v14, 3, v6
    v_lshl_add_u32 v14, v5, 1, v14
    v_add_u32 v14, s42, v14
    global_load_ushort v40, v14, s[4:5]
    s_add_u32 m0, s46, 0
    s_nop 0
    global_load_lds_dwordx4 v12, s[16:17]
    s_add_u32 m0, s46, 1024
    s_nop 0
    global_load_lds_dwordx4 v12, s[18:19]
    v_bfe_u32 v13, v0, 2, 2
    v_lshl_add_u32 v12, v13, 2, v5
    v_sub_u32 v13, 7, v13
    v_lshl_add_u32 v13, v13, 2, v5
    v_and_b32 v14, 3, v0
    v_lshl_add_u32 v14, v14, 3, s46
    v_lshl_add_u32 v12, v12, 5, v14
    v_lshl_add_u32 v13, v13, 5, v14
    s_waitcnt vmcnt(0)
    ds_read_b64_tr_b16 v[32:33], v12 offset:0
    ds_read_b64_tr_b16 v[34:35], v13 offset:0
    ds_read_b64_tr_b16 v[36:37], v12 offset:1024
    ds_read_b64_tr_b16 v[38:39], v13 offset:1024
    s_lshl_b32 s42, s43, 7
    s_add_u32 s42, s42, 524288
    v_lshrrev_b32 v14, 3, v0
    v_lshlrev_b32 v14, 11, v14
    v_lshl_add_u32 v14, v6, 4, v14
    v_add_u32 v14, s42, v14
    s_lshl_b32 s42, s43, 4
    v_mul_u32_u24 v15, 272, v4
    v_add_u32 v15, s42, v15
    s_lshl_b32 s42, s43, 3
    v_mov_b32 v13, s42
    v_add_u32 v15, 9216, v15
    v_cmp_eq_u32 s[50:51], 1, v4
    v_mov_b32 v46, 0x3f803f80
    s_barrier
    s_mov_b32 s47, 0
Lp2:
    global_load_dwordx4 v[16:19], v14, s[26:27] sc1
    s_waitcnt vmcnt(0)
    v_max3_u32 v3, v16, v17, v18
    v_max_u32 v3, v3, v19
    v_cmpx_eq_u32 vcc, -1, v3
    s_add_u32 s47, s47, 1
    s_cbranch_execz Lp2d
    s_cmp_lt_u32 s47, 131072
    s_cbranch_scc1 Lp2
Lp2d:
    s_mov_b64 exec, -1
    s_nop 1
    v_permlane16_swap_b32 v16, v17
    v_permlane16_swap_b32 v18, v19
    v_lshlrev_b32 v40, 16, v40
    v_add_f32 v16, v16, v17
    v_add_f32 v18, v18, v19
    s_nop 1
    v_permlane32_swap_b32 v16, v18
    s_nop 0
    v_add_f32 v16, v16, v18
    s_nop 1
    v_add_f32_dpp v16, v16, v16 row_ror:8 row_mask:0xf bank_mask:0xf
    v_cvt_pk_bf16_f32 v16, v16, v16
    v_lshlrev_b32 v16, 16, v16
    v_add_f32 v16, v16, v40
    s_nop 1
    v_mov_b32_dpp v17, v16 quad_perm:[1,0,3,2] row_mask:0xf bank_mask:0xf
    v_cvt_pk_bf16_f32 v24, v16, v17
    s_nop 1
    v_mov_b32_dpp v25, v24 quad_perm:[2,3,0,1] row_mask:0xf bank_mask:0xf
    v_mov_b32_dpp v26, v24 row_half_mirror row_mask:0xf bank_mask:0xf
    s_nop 0
    v_mov_b32_dpp v27, v25 row_half_mirror row_mask:0xf bank_mask:0xf
    v_cndmask_b32 v24, v24, v46, s[50:51]
    v_cndmask_b32 v25, v25, v46, s[50:51]
    v_cndmask_b32 v26, v26, v46, s[50:51]
    v_cndmask_b32 v27, v27, v46, s[50:51]
    s_waitcnt lgkmcnt(0)
    s_nop 0
    v_mfma_f32_16x16x32_bf16 v[48:51], v[24:27], v[24:27], 0
    v_mfma_f32_16x16x32_bf16 v[8:11], v[24:27], v[32:35], 0
    v_mfma_f32_16x16x32_bf16 v[28:31], v[24:27], v[36:39], 0
    s_mov_b64 exec, 1
    s_nop 4
    ds_write_b64 v13, v[48:49] offset:14336
    s_mov_b64 exec, 0xffff
    ds_write2_b64 v15, v[8:9], v[28:29] offset0:0 offset1:1
    s_mov_b64 exec, -1
    v_lshrrev_b32 v12, 2, v0
    v_mul_u32_u24 v13, 272, v12
    v_and_b32 v14, 3, v0
    v_lshl_add_u32 v13, v14, 6, v13
    v_lshlrev_b32 v14, 5, v14
    s_lshl_b32 s40, s33, 7
    s_add_u32 s40, s40, 557056
    v_lshl_add_u32 v12, v12, 1, s40
    s_waitcnt lgkmcnt(0)
    s_barrier
    s_cmp_lg_u32 s3, 0
    s_cbranch_scc1 Lfin
    ds_read_b128 v[32:35], v14 offset:14336
    ds_read_b128 v[36:39], v14 offset:14352
    ds_read_b128 v[16:19], v13 offset:9216
    ds_read_b128 v[20:23], v13 offset:9232
    ds_read_b128 v[24:27], v13 offset:9248
    ds_read_b128 v[28:31], v13 offset:9264
    s_mov_b32 s42, 0x1010101
    s_mov_b32 s43, s42
    s_waitcnt lgkmcnt(4)
    v_pk_add_f32 v[32:33], v[32:33], v[34:35]
    v_pk_add_f32 v[36:37], v[36:37], v[38:39]
    v_pk_add_f32 v[32:33], v[32:33], v[36:37]
    s_nop 0
    s_nop 0
    v_add_f32_dpp v32, v32, v32 quad_perm:[1,0,3,2] row_mask:0xf bank_mask:0xf
    v_add_f32_dpp v33, v33, v33 quad_perm:[1,0,3,2] row_mask:0xf bank_mask:0xf
    s_nop 0
    v_add_f32_dpp v32, v32, v32 quad_perm:[2,3,0,1] row_mask:0xf bank_mask:0xf
    v_add_f32_dpp v33, v33, v33 quad_perm:[2,3,0,1] row_mask:0xf bank_mask:0xf
    v_mul_f32 v33, 0x3b000000, v33
    v_mul_f32 v32, 0x3b000000, v32
    v_fma_f32 v32, -v33, v33, v32
    v_max_f32 v32, 0, v32
    v_cvt_pk_bf16_f32 v34, v32, v33
    v_lshlrev_b32 v32, 16, v34
    v_and_b32 v33, 0xffff0000, v34
    v_add_f32 v32, 0x3727c5ac, v32
    v_cvt_pk_bf16_f32 v32, v32, v32
    v_lshlrev_b32 v32, 16, v32
    v_sqrt_f32 v32, v32
    s_waitcnt lgkmcnt(0)
    v_pk_add_f32 v[16:17], v[16:17], v[20:21]
    v_cvt_pk_bf16_f32 v32, v32, v32
    v_lshlrev_b32 v32, 16, v32
    v_pk_add_f32 v[18:19], v[18:19], v[22:23]
    v_rcp_f32 v32, v32
    v_pk_add_f32 v[24:25], v[24:25], v[28:29]
    v_pk_add_f32 v[26:27], v[26:27], v[30:31]
    v_pk_add_f32 v[16:17], v[16:17], v[24:25]
    v_pk_add_f32 v[18:19], v[18:19], v[26:27]
    v_fma_f32 v16, -v33, v17, v16
    v_fma_f32 v18, -v33, v19, v18
    s_nop 0
    v_add_f32_dpp v16, v16, v16 quad_perm:[1,0,3,2] row_mask:0xf bank_mask:0xf
    v_add_f32_dpp v18, v18, v18 quad_perm:[1,0,3,2] row_mask:0xf bank_mask:0xf
    s_nop 0
    v_add_f32_dpp v16, v16, v16 quad_perm:[2,3,0,1] row_mask:0xf bank_mask:0xf
    v_add_f32_dpp v18, v18, v18 quad_perm:[2,3,0,1] row_mask:0xf bank_mask:0xf
    v_mul_f32 v16, v16, v32
    v_mul_f32 v18, v18, v32
    v_cvt_pk_bf16_f32 v17, v16, v18
    v_lshlrev_b32 v16, 16, v17
    v_and_b32 v18, 0xffff0000, v17
    v_cmp_lt_f32 vcc, 0, v16
    s_nop 1
    v_cndmask_b32 v17, 0, 1.0, vcc
    v_mul_f32 v16, v16, v17
    v_mul_f32 v16, v16, v18
    s_nop 1
    v_mov_b32_dpp v17, v16 row_shl:4 row_mask:0xf bank_mask:0xf
    v_cvt_pk_bf16_f32 v16, v16, v17
    v_min_u32 v16, -2, v16
    s_mov_b64 exec, s[42:43]
    global_store_dword v12, v16, s[26:27] sc1
    s_mov_b64 exec, -1
    s_branch Lfin
LC:
    s_lshl_b32 s43, s33, 2
    s_add_u32 s43, s43, s3
    s_and_b32 s43, s43, 15
    s_lshl_b32 s40, s43, 15
    s_lshl_b32 s41, s33, 5
    s_add_u32 s40, s40, s41
    v_lshrrev_b32 v12, 1, v0
    v_lshlrev_b32 v12, 10, v12
    v_and_b32 v13, 0x10, v1
    v_add3_u32 v12, v12, v13, s40
    s_add_u32 m0, s46, 0
    s_nop 0
    global_load_lds_dwordx4 v12, s[20:21]
    v_add_u32 v12, 0x80000, v12
    s_add_u32 m0, s46, 1024
    s_nop 0
    global_load_lds_dwordx4 v12, s[20:21]
    v_add_u32 v12, 0x80000, v12
    s_cmp_ge_u32 s43, 11
    s_cbranch_scc1 LC0
    s_add_u32 m0, s46, 2048
    s_nop 0
    global_load_lds_dwordx4 v12, s[20:21]
LC0:
    s_waitcnt vmcnt(0)
    v_lshlrev_b32 v12, 8, v5
    v_lshl_add_u32 v12, v4, 3, v12
    v_add_u32 v12, s46, v12
    ds_read_b64_tr_b16 v[32:33], v12 offset:0
    ds_read_b64_tr_b16 v[34:35], v12 offset:128
    ds_read_b64_tr_b16 v[36:37], v12 offset:1024
    ds_read_b64_tr_b16 v[38:39], v12 offset:1152
    ds_read_b64_tr_b16 v[40:41], v12 offset:2048
    ds_read_b64_tr_b16 v[42:43], v12 offset:2176
    s_lshl_b32 s42, s43, 8
    s_add_u32 s42, s42, 557056
    v_lshrrev_b32 v13, 5, v0
    v_lshlrev_b32 v13, 7, v13
    v_and_b32 v14, 16, v0
    v_add3_u32 v13, v13, v14, s42
    v_lshl_add_u32 v13, v4, 12, v13
    s_cmp_lt_u32 s43, 11
    s_cselect_b32 s52, 7, 3
    s_mul_i32 s52, s52, 0x10001
    s_mov_b32 s53, s52
    v_mov_b32 v20, 0
    v_mov_b32 v21, 0
    v_mov_b32 v22, 0
    v_mov_b32 v23, 0
    s_lshl_b32 s42, s43, 2
    v_mul_u32_u24 v15, 80, v4
    v_add_u32 v15, s42, v15
    s_waitcnt lgkmcnt(0)
    s_cmp_lt_u32 s43, 11
    s_cbranch_scc1 LC1
    v_mov_b32 v40, 0
    v_mov_b32 v41, 0
    v_mov_b32 v42, 0
    v_mov_b32 v43, 0
LC1:
    v_lshrrev_b32 v44, 2, v0
    s_lshl_b32 s42, s33, 5
    v_lshl_add_u32 v45, v44, 1, s42
    s_cmp_lg_u32 s3, 0
    s_cbranch_scc1 LC2
    global_load_ushort v47, v45, s[4:5]
    v_and_b32 v46, 3, v0
    v_and_b32 v48, 1, v46
    v_lshlrev_b32 v48, 13, v48
    v_lshrrev_b32 v49, 1, v46
    v_lshl_add_u32 v48, v49, 11, v48
    v_lshl_add_u32 v48, v45, 1, v48
    v_add_u32 v48, 524288, v48
    v_add_u32 v49, 4096, v48
    v_mul_u32_u24 v44, 80, v44
    v_lshl_add_u32 v44, v46, 4, v44
    s_mov_b32 s47, 0
Lp3:
    global_load_dword v16, v48, s[26:27] sc1
    global_load_dword v17, v49, s[26:27] sc1
    s_waitcnt vmcnt(0)
    v_max3_u32 v3, v16, v17, v17
    v_cmpx_eq_u32 vcc, -1, v3
    s_add_u32 s47, s47, 1
    s_cbranch_execz Lp3d
    s_cmp_lt_u32 s47, 131072
    s_cbranch_scc1 Lp3
Lp3d:
    s_mov_b64 exec, -1
    s_nop 1
    v_add_f32 v16, v16, v17
    v_lshlrev_b32 v47, 16, v47
    s_nop 1
    v_add_f32_dpp v16, v16, v16 quad_perm:[1,0,3,2] row_mask:0xf bank_mask:0xf
    s_nop 1
    v_add_f32_dpp v16, v16, v16 quad_perm:[2,3,0,1] row_mask:0xf bank_mask:0xf
    v_cvt_pk_bf16_f32 v16, v16, v16
    v_lshlrev_b32 v16, 16, v16
    v_add_f32 v47, v47, v16
    v_cvt_pk_bf16_f32 v47, v47, v47
    v_lshlrev_b32 v47, 16, v47
LC2:
    s_barrier
    s_mov_b64 exec, s[52:53]
    s_mov_b32 s47, 0
Lp4:
    global_load_dwordx4 v[20:23], v13, s[26:27] sc1
    s_waitcnt vmcnt(0)
    v_max3_u32 v3, v20, v21, v22
    v_max_u32 v3, v3, v23
    v_cmpx_eq_u32 vcc, -1, v3
    s_add_u32 s47, s47, 1
    s_cbranch_execz Lp4d
    s_cmp_lt_u32 s47, 131072
    s_cbranch_scc1 Lp4
Lp4d:
    s_mov_b64 exec, -1
    s_nop 1
    s_mov_b64 exec, -1
    v_mfma_f32_16x16x32_bf16 v[8:11], v[20:23], v[32:35], 0
    v_mfma_f32_16x16x32_bf16 v[24:27], v[20:23], v[36:39], 0
    v_mfma_f32_16x16x32_bf16 v[28:31], v[20:23], v[40:43], 0
    s_mov_b64 exec, 0xffff
    s_nop 5
    v_add_f32 v8, v8, v25
    v_add_f32 v8, v8, v30
    ds_write_b32 v15, v8 offset:9216
    s_mov_b64 exec, -1
    s_waitcnt lgkmcnt(0)
    s_barrier
    s_cmp_lg_u32 s3, 0
    s_cbranch_scc1 Lfin
    ds_read_b128 v[16:19], v44 offset:9216
    s_mov_b32 s42, 0x11111111
    s_mov_b32 s43, s42
    s_waitcnt lgkmcnt(0)
    v_pk_add_f32 v[16:17], v[16:17], v[18:19]
    v_add_f32 v16, v16, v17
    s_nop 1
    v_add_f32_dpp v16, v16, v16 quad_perm:[1,0,3,2] row_mask:0xf bank_mask:0xf
    s_nop 1
    v_add_f32_dpp v16, v16, v16 quad_perm:[2,3,0,1] row_mask:0xf bank_mask:0xf
    v_cvt_pk_bf16_f32 v16, v16, v16
    v_lshlrev_b32 v16, 16, v16
    v_add_f32 v16, v16, v47
    v_cvt_pk_bf16_f32 v16, v16, v16
    s_mov_b64 exec, s[42:43]
    global_store_short v45, v16, s[22:23]
    s_mov_b64 exec, -1
Lfin:
Lend:
    s_endpgm
.section .rodata,"a"
.p2align 6
.amdhsa_kernel sequential_preLN__sliding_block_cached__glu_gated_reglu__decode_kernel
  .amdhsa_next_free_vgpr 128
  .amdhsa_next_free_sgpr 64
  .amdhsa_accum_offset 128
  .amdhsa_group_segment_fixed_size 0
  .amdhsa_kernarg_size 96
  .amdhsa_user_sgpr_count 2
  .amdhsa_user_sgpr_kernarg_segment_ptr 1
  .amdhsa_system_sgpr_workgroup_id_x 1
.end_amdhsa_kernel
```
